```python
import torch

def _softmax(x, axis=-1):
    return torch.softmax(x, dim=axis)
def _gelu(x):
    return torch.nn.functional.gelu(x, approximate="tanh")
def _silu(x):
    return torch.nn.functional.silu(x)
def _sigmoid(x):
    return torch.sigmoid(x)
def _layernorm(x, axis=-1, eps=1e-5):
    m = x.mean(dim=axis, keepdim=True)
    v = x.var(dim=axis, keepdim=True, unbiased=False)
    return (x - m) / torch.sqrt(v + eps)
def _scatter_add(tgt, idx, src, axis=0):
    return tgt.clone().index_add_(axis, idx, src)
def _segment_sum(src, seg, n):
    out = torch.zeros((n,) + src.shape[1:], dtype=src.dtype)
    return out.index_add_(0, seg, src)
def _pad(x, pw):
    flat = tuple(v for pair in reversed(pw) for v in pair)
    return torch.nn.functional.pad(x, flat)

kernel_name = 'recurrent_scan__sliding_block_cached__swiglu_ffn__decode'

def setup_inputs():

    _w = (lambda a: (lambda t: t.to(torch.bfloat16) if t.is_floating_point() else t)(torch.as_tensor(a)))
    def _A_setup():
        B, Sq, D = 1, 1, 512
        Hq, Hkv, Sk, Dh = 32, 8, 65536, 128
        assert Hq % Hkv == 0, (Hq, Hkv)
        return {
            "x": _w((lambda *s: torch.randn(*s, dtype=torch.bfloat16) * 0.05)(B, Sq, D)),
            "k_cache": _w((lambda *s: torch.randn(*s, dtype=torch.bfloat16) * 1.6)(B, Hkv, Sk, Dh)),
            "v_cache": _w((lambda *s: torch.randn(*s, dtype=torch.bfloat16) * 0.2)(B, Hkv, Sk, Dh)),
            "wq": _w((lambda *s: torch.randn(*s, dtype=torch.bfloat16) * 1.6)(D, Hq * Dh) * (D ** -0.5)),
            "wo": _w((lambda *s: torch.randn(*s, dtype=torch.bfloat16) * 0.2)(Hq * Dh, D) * ((Hq * Dh) ** -0.5)),
        }
    _A_in = _A_setup()

    def _B_setup():
        B, S, D, F = 1, 1, 512, 1792
        return {
            "x": _w((lambda *s: torch.randn(*s, dtype=torch.bfloat16) * 0.05)(B, S, D)),
            "w_gate": _w((lambda *s: torch.randn(*s, dtype=torch.bfloat16) * 0.1)(D, F)),
            "w_up": _w((lambda *s: torch.randn(*s, dtype=torch.bfloat16) * 0.1)(D, F)),
            "w_down": _w((lambda *s: torch.randn(*s, dtype=torch.bfloat16) * 0.1)(F, D)),
        }
    _B_in = _B_setup()

    return {
        "A_x": _A_in["x"],
        "A_k_cache": _A_in["k_cache"],
        "A_v_cache": _A_in["v_cache"],
        "A_wq": _A_in["wq"],
        "A_wo": _A_in["wo"],
        "B_x": _B_in["x"],
        "B_w_gate": _B_in["w_gate"],
        "B_w_up": _B_in["w_up"],
        "B_w_down": _B_in["w_down"],
    }

def reference(A_x, A_k_cache, A_v_cache, A_wq, A_wo, B_x, B_w_gate, B_w_up, B_w_down):
    def _A_ref(x, k_cache, v_cache, wq, wo):
        B, Sq, D = x.shape
        Hq, Dh = 32, 128
        Hkv, Sk = k_cache.shape[1], k_cache.shape[2]
        W = min(4096, max(256, Sk // 4))
        rep = Hq // Hkv
        q = (lambda x, *d: x.permute(*d))((x @ wq).reshape(B, Sq, Hq, Dh), 0, 2, 1, 3)
        k = (lambda x, n, axis: torch.repeat_interleave(x, n, dim=axis))(k_cache[:, :, Sk - W:, :], rep, axis=1)
        v = (lambda x, n, axis: torch.repeat_interleave(x, n, dim=axis))(v_cache[:, :, Sk - W:, :], rep, axis=1)
        scores = torch.einsum("bhqd,bhkd->bhqk", q, k) * (Dh ** -0.5)
        p = _softmax(scores, axis=-1)
        o = torch.einsum("bhqk,bhkd->bhqd", p, v)
        return (lambda x, *d: x.permute(*d))(o, 0, 2, 1, 3).reshape(B, Sq, Hq * Dh) @ wo

    def _B_ref(x, w_gate, w_up, w_down):
        g = _silu(x @ w_gate)
        u = x @ w_up
        return (g * u) @ w_down

    x = A_x
    xn = _layernorm(x, axis=-1)
    s = _A_ref(xn, A_k_cache, A_v_cache, A_wq, A_wo)
    g = _silu(_B_ref(xn, B_w_gate, B_w_up, B_w_down))
    return x + s * g
```

```asm
; @launch grid=(256,1,1) block=(384,1,1) lds=12800
.amdgcn_target "amdgcn-amd-amdhsa--gfx950"
.text
.globl recurrent_scan__sliding_block_cached__swiglu_ffn__decode_kernel
.p2align 12
.p2align 8
.type recurrent_scan__sliding_block_cached__swiglu_ffn__decode_kernel,@function
recurrent_scan__sliding_block_cached__swiglu_ffn__decode_kernel:
    s_load_dwordx16 s[4:19], s[0:1], 0
    s_load_dwordx8 s[20:27], s[0:1], 64
    s_cmp_ge_u32 s2, 256
    s_cbranch_scc1 L_end
    v_lshrrev_b32 v2, 6, v0
    v_and_b32 v0, 63, v0
    v_readfirstlane_b32 s3, v2
    s_and_b32 s28, s2, 7
    s_lshr_b32 s29, s2, 3
    v_lshrrev_b32 v1, 4, v0
    v_lshrrev_b32 v30, 3, v0
    v_and_b32 v31, 7, v0
    v_and_b32 v32, 3, v0
    v_lshlrev_b32 v34, 4, v0
    s_cmp_eq_u32 s3, 0
    s_cbranch_scc1 L_Q0
    s_cmp_eq_u32 s3, 1
    s_cbranch_scc1 L_F0
    s_sub_u32 s3, s3, 2
    s_getpc_b64 s[48:49]
    s_and_b32 s48, s48, 0xffffff00
    s_lshl2_add_u32 s47, s29, s3
    s_lshl_b32 s31, s47, 7
    s_cmp_lt_u32 s31, L_end-recurrent_scan__sliding_block_cached__swiglu_ffn__decode_kernel-256
    s_cbranch_scc0 L_nopf
    v_mov_b32 v7, s31
    s_mov_b64 exec, 1
    global_load_dword v150, v7, s[48:49]
    s_mov_b64 exec, -1
L_nopf:
    s_lshl_b32 s30, s28, 24
    s_lshl_b32 s31, s29, 15
    s_add_u32 s30, s30, s31
    s_add_u32 s30, s30, 15728640
    s_add_u32 s31, s28, s3
    s_and_b32 s31, s31, 7
    s_lshl_b32 s31, s31, 12
    s_add_u32 s34, s31, s30
    s_xor_b32 s31, s31, 0x4000
    s_add_u32 s35, s31, s30
    v_bfe_u32 v6, v0, 2, 2
    v_lshlrev_b32 v9, 4, v32
    v_lshl_add_u32 v45, v1, 6, v9
    v_lshl_add_u32 v45, v6, 8, v45
    v_add_u32 v35, s34, v45
    v_add_u32 v36, s35, v45
    v_add_u32 v37, s34, v34
    v_add_u32 v38, s35, v34
    s_waitcnt lgkmcnt(0)
    s_load_dword s33, s[26:27], 0
    s_barrier
    global_load_dwordx4 v[58:61], v35, s[6:7] offset:0 nt
    s_barrier
    global_load_dwordx4 v[62:65], v35, s[6:7] offset:1024 nt
    s_branch L_A1
L_F0:
    s_cmp_gt_u32 s28, 4
    s_subb_u32 s30, s28, 0
    s_cmp_eq_u32 s28, 4
    s_cselect_b32 s30, 7, s30
    s_lshr_b32 s31, s29, 3
    s_lshl2_add_u32 s47, s30, s31
    s_and_b32 s40, s29, 7
    s_lshl_b32 s30, s40, 6
    v_lshl_add_u32 v6, v30, 1, s30
    v_lshl_add_u32 v3, v32, 4, v6
    v_lshlrev_b32 v3, 1, v3
    s_lshl_b32 s31, s47, 7
    v_lshl_add_u32 v35, v31, 4, s31
    s_movk_i32 s30, 3584
    v_mad_u32_u24 v35, v6, s30, v35
    s_mov_b32 s32, 57344
    s_lshl3_add_u32 s30, s47, s40
    s_lshl_b32 s30, s30, 9
    s_add_u32 s34, s30, 262144
    v_lshl_add_u32 v4, v0, 7, s34
    s_waitcnt lgkmcnt(0)
    s_load_dword s33, s[26:27], 0
    s_cmp_eq_u32 s28, 4
    s_cbranch_scc1 L_F0n
    global_load_dwordx4 v[44:47], v34, s[4:5]
    global_load_dword v41, v3, s[4:5]
    s_barrier
    global_load_dwordx4 v[48:51], v35, s[16:17] offset:0 nt
    global_load_dwordx4 v[52:55], v35, s[18:19] offset:0 nt
    s_barrier
    global_load_dwordx4 v[56:59], v35, s[16:17] offset:3584 nt
    global_load_dwordx4 v[60:63], v35, s[18:19] offset:3584 nt
    s_mov_b64 exec, 15
    global_load_dword v143, v4, s[26:27] nt
    s_mov_b64 exec, -1
    s_branch L_F1
L_F0n:
    s_barrier
    s_barrier
    s_branch L_F1
L_Q0:
    s_lshr_b32 s30, s29, 3
    s_lshl_b32 s30, s30, 7
    v_lshl_add_u32 v6, v30, 2, s30
    v_lshl_add_u32 v3, v32, 5, v6
    v_lshlrev_b32 v3, 1, v3
    s_and_b32 s32, s29, 7
    s_lshl3_add_u32 s31, s28, s32
    s_lshl_b32 s31, s31, 7
    v_lshl_add_u32 v35, v31, 4, s31
    v_lshl_add_u32 v35, v6, 13, v35
    s_movk_i32 s34, 0x2000
    s_mov_b32 s35, 237568
    s_lshl_b32 s47, s28, 5
    s_add_u32 s47, s47, s29
    s_lshl_b32 s30, s47, 8
    s_add_u32 s40, s30, 65536
    v_lshl_add_u32 v4, v0, 7, s40
    s_lshl_b32 s30, s47, 11
    s_add_u32 s30, s30, 524288
    v_lshl_add_u32 v38, v0, 7, s30
    s_waitcnt lgkmcnt(0)
    global_load_dwordx4 v[40:43], v34, s[4:5]
    global_load_dwordx2 v[44:45], v3, s[4:5]
    global_load_dwordx4 v[46:49], v35, s[10:11] nt
    v_add_u32 v35, s34, v35
    global_load_dwordx4 v[50:53], v35, s[10:11] nt
    v_add_u32 v35, s34, v35
    global_load_dwordx4 v[54:57], v35, s[10:11] nt
    v_add_u32 v35, s34, v35
    global_load_dwordx4 v[58:61], v35, s[10:11] nt
    v_add_u32 v35, s35, v35
    global_load_dwordx4 v[62:65], v35, s[10:11] nt
    v_add_u32 v35, s34, v35
    global_load_dwordx4 v[66:69], v35, s[10:11] nt
    v_add_u32 v35, s34, v35
    global_load_dwordx4 v[70:73], v35, s[10:11] nt
    v_add_u32 v35, s34, v35
    global_load_dwordx4 v[74:77], v35, s[10:11] nt
    s_mov_b64 exec, 3
    global_load_dword v122, v4, s[26:27] nt
    s_mov_b64 exec, -1
    v_add_u32 v35, s35, v35
    global_load_dwordx4 v[78:81], v35, s[10:11] nt
    v_add_u32 v35, s34, v35
    global_load_dwordx4 v[82:85], v35, s[10:11] nt
    v_add_u32 v35, s34, v35
    global_load_dwordx4 v[86:89], v35, s[10:11] nt
    v_add_u32 v35, s34, v35
    global_load_dwordx4 v[90:93], v35, s[10:11] nt
    v_add_u32 v35, s35, v35
    global_load_dwordx4 v[94:97], v35, s[10:11] nt
    v_add_u32 v35, s34, v35
    global_load_dwordx4 v[98:101], v35, s[10:11] nt
    v_add_u32 v35, s34, v35
    global_load_dwordx4 v[102:105], v35, s[10:11] nt
    v_add_u32 v35, s34, v35
    global_load_dwordx4 v[106:109], v35, s[10:11] nt
    s_load_dword s33, s[26:27], 0
    s_barrier
    s_barrier
    v_and_b32 v3, 1, v0
    v_lshlrev_b32 v3, 4, v3
    v_mov_b32 v4, 0xffff
    v_lshlrev_b32 v3, v3, v4
    v_lshrrev_b32 v4, 1, v31
    v_cmp_eq_u32 s[48:49], 0, v4
    v_cmp_eq_u32 s[50:51], 1, v4
    v_cmp_eq_u32 s[30:31], 2, v4
    v_cmp_eq_u32 s[34:35], 3, v4
    v_cndmask_b32 v26, 0, v3, s[48:49]
    v_cndmask_b32 v27, 0, v3, s[50:51]
    v_cndmask_b32 v28, 0, v3, s[30:31]
    v_cndmask_b32 v29, 0, v3, s[34:35]
    v_mov_b32 v33, 0xffffff00
    v_and_b32 v3, 1, v1
    v_lshl_add_u32 v3, v31, 1, v3
    v_lshl_add_u32 v36, v3, 4, s40
    s_lshl_b32 s30, s28, 13
    s_add_u32 s30, s30, 69632
    v_add_u32 v37, s30, v34
    s_mov_b32 s44, 0
    s_waitcnt vmcnt(17)
    v_readfirstlane_b32 s30, v40
    v_lshlrev_b32 v10, 16, v40
    v_and_b32 v11, 0xffff0000, v40
    v_lshlrev_b32 v12, 16, v41
    v_and_b32 v13, 0xffff0000, v41
    v_lshlrev_b32 v14, 16, v42
    v_and_b32 v15, 0xffff0000, v42
    v_lshlrev_b32 v16, 16, v43
    v_and_b32 v17, 0xffff0000, v43
    s_lshl_b32 s30, s30, 16
    s_mov_b32 s31, s30
    v_pk_add_f32 v[10:11], v[10:11], s[30:31] neg_lo:[0,1] neg_hi:[0,1]
    v_pk_add_f32 v[12:13], v[12:13], s[30:31] neg_lo:[0,1] neg_hi:[0,1]
    v_pk_add_f32 v[14:15], v[14:15], s[30:31] neg_lo:[0,1] neg_hi:[0,1]
    v_pk_add_f32 v[16:17], v[16:17], s[30:31] neg_lo:[0,1] neg_hi:[0,1]
    v_pk_add_f32 v[2:3], v[10:11], v[12:13]
    v_pk_mul_f32 v[4:5], v[10:11], v[10:11]
    v_pk_add_f32 v[2:3], v[2:3], v[14:15]
    v_pk_fma_f32 v[4:5], v[12:13], v[12:13], v[4:5]
    v_pk_add_f32 v[2:3], v[2:3], v[16:17]
    v_pk_fma_f32 v[4:5], v[14:15], v[14:15], v[4:5]
    v_pk_fma_f32 v[4:5], v[16:17], v[16:17], v[4:5]
    v_add_f32 v2, v2, v3
    v_add_f32 v3, v4, v5
    v_lshlrev_b32 v10, 16, v44
    v_add_f32_dpp v2, v2, v2 row_ror:8 row_mask:0xf bank_mask:0xf
    v_add_f32_dpp v3, v3, v3 row_ror:8 row_mask:0xf bank_mask:0xf
    v_and_b32 v11, 0xffff0000, v44
    v_add_f32_dpp v2, v2, v2 row_ror:4 row_mask:0xf bank_mask:0xf
    v_add_f32_dpp v3, v3, v3 row_ror:4 row_mask:0xf bank_mask:0xf
    v_lshlrev_b32 v12, 16, v45
    v_add_f32_dpp v2, v2, v2 row_ror:2 row_mask:0xf bank_mask:0xf
    v_add_f32_dpp v3, v3, v3 row_ror:2 row_mask:0xf bank_mask:0xf
    v_and_b32 v13, 0xffff0000, v45
    v_add_f32_dpp v2, v2, v2 row_ror:1 row_mask:0xf bank_mask:0xf
    v_add_f32_dpp v3, v3, v3 row_ror:1 row_mask:0xf bank_mask:0xf
    v_mov_b32 v4, v2
    v_mov_b32 v5, v3
    s_nop 0
    v_permlane16_swap_b32 v2, v4
    v_permlane16_swap_b32 v3, v5
    v_add_f32 v2, v2, v4
    v_add_f32 v3, v3, v5
    v_mov_b32 v4, v2
    v_mov_b32 v5, v3
    s_nop 0
    v_permlane32_swap_b32 v2, v4
    v_permlane32_swap_b32 v3, v5
    v_add_f32 v2, v2, v4
    v_add_f32 v3, v3, v5
    v_mul_f32 v2, 0x3b000000, v2
    v_mul_f32 v3, 0x3b000000, v3
    v_fma_f32 v3, -v2, v2, v3
    v_add_f32 v2, s30, v2
    v_max_f32 v3, 0, v3
    v_cvt_pk_bf16_f32 v2, v2, v3
    v_and_b32 v4, 0xffff0000, v2
    v_lshlrev_b32 v2, 16, v2
    v_add_f32 v4, 0x3727c5ac, v4
    v_pk_add_f32 v[10:11], v[10:11], v[2:3] op_sel_hi:[1,0] neg_lo:[0,1] neg_hi:[0,1]
    v_pk_add_f32 v[12:13], v[12:13], v[2:3] op_sel_hi:[1,0] neg_lo:[0,1] neg_hi:[0,1]
    v_cvt_pk_bf16_f32 v4, v4, v4
    v_lshlrev_b32 v4, 16, v4
    v_sqrt_f32 v4, v4
    v_cvt_pk_bf16_f32 v6, v10, v11
    v_cvt_pk_bf16_f32 v7, v12, v13
    v_cvt_pk_bf16_f32 v4, v4, v4
    v_lshlrev_b32 v4, 16, v4
    v_rcp_f32 v4, v4
    v_lshlrev_b32 v10, 16, v6
    v_and_b32 v11, 0xffff0000, v6
    v_lshlrev_b32 v12, 16, v7
    v_and_b32 v13, 0xffff0000, v7
    v_pk_mul_f32 v[10:11], v[10:11], v[4:5] op_sel_hi:[1,0]
    v_pk_mul_f32 v[12:13], v[12:13], v[4:5] op_sel_hi:[1,0]
    v_cvt_pk_bf16_f32 v10, v10, v10
    v_cvt_pk_bf16_f32 v11, v11, v11
    v_cvt_pk_bf16_f32 v12, v12, v12
    v_cvt_pk_bf16_f32 v13, v13, v13
    v_and_b32_dpp v110, v10, v26 quad_perm:[0,0,0,0] row_mask:0xf bank_mask:0xf
    v_and_b32_dpp v111, v10, v27 quad_perm:[0,0,0,0] row_mask:0xf bank_mask:0xf
    v_and_b32_dpp v112, v10, v28 quad_perm:[0,0,0,0] row_mask:0xf bank_mask:0xf
    v_and_b32_dpp v113, v10, v29 quad_perm:[0,0,0,0] row_mask:0xf bank_mask:0xf
    s_waitcnt vmcnt(16)
    s_nop 0
    v_mfma_f32_16x16x32_bf16 v[118:121], v[110:113], v[46:49], 0
    v_and_b32_dpp v114, v11, v26 quad_perm:[0,0,0,0] row_mask:0xf bank_mask:0xf
    v_and_b32_dpp v115, v11, v27 quad_perm:[0,0,0,0] row_mask:0xf bank_mask:0xf
    v_and_b32_dpp v116, v11, v28 quad_perm:[0,0,0,0] row_mask:0xf bank_mask:0xf
    v_and_b32_dpp v117, v11, v29 quad_perm:[0,0,0,0] row_mask:0xf bank_mask:0xf
    s_waitcnt vmcnt(15)
    s_nop 0
    v_mfma_f32_16x16x32_bf16 v[118:121], v[114:117], v[50:53], v[118:121]
    v_and_b32_dpp v110, v12, v26 quad_perm:[0,0,0,0] row_mask:0xf bank_mask:0xf
    v_and_b32_dpp v111, v12, v27 quad_perm:[0,0,0,0] row_mask:0xf bank_mask:0xf
    v_and_b32_dpp v112, v12, v28 quad_perm:[0,0,0,0] row_mask:0xf bank_mask:0xf
    v_and_b32_dpp v113, v12, v29 quad_perm:[0,0,0,0] row_mask:0xf bank_mask:0xf
    s_waitcnt vmcnt(14)
    s_nop 0
    v_mfma_f32_16x16x32_bf16 v[118:121], v[110:113], v[54:57], v[118:121]
    v_and_b32_dpp v114, v13, v26 quad_perm:[0,0,0,0] row_mask:0xf bank_mask:0xf
    v_and_b32_dpp v115, v13, v27 quad_perm:[0,0,0,0] row_mask:0xf bank_mask:0xf
    v_and_b32_dpp v116, v13, v28 quad_perm:[0,0,0,0] row_mask:0xf bank_mask:0xf
    v_and_b32_dpp v117, v13, v29 quad_perm:[0,0,0,0] row_mask:0xf bank_mask:0xf
    s_waitcnt vmcnt(13)
    s_nop 0
    v_mfma_f32_16x16x32_bf16 v[118:121], v[114:117], v[58:61], v[118:121]
    v_and_b32_dpp v110, v10, v26 quad_perm:[1,1,1,1] row_mask:0xf bank_mask:0xf
    v_and_b32_dpp v111, v10, v27 quad_perm:[1,1,1,1] row_mask:0xf bank_mask:0xf
    v_and_b32_dpp v112, v10, v28 quad_perm:[1,1,1,1] row_mask:0xf bank_mask:0xf
    v_and_b32_dpp v113, v10, v29 quad_perm:[1,1,1,1] row_mask:0xf bank_mask:0xf
    s_waitcnt vmcnt(12)
    s_barrier
    v_mfma_f32_16x16x32_bf16 v[118:121], v[110:113], v[62:65], v[118:121]
    v_and_b32_dpp v114, v11, v26 quad_perm:[1,1,1,1] row_mask:0xf bank_mask:0xf
    v_and_b32_dpp v115, v11, v27 quad_perm:[1,1,1,1] row_mask:0xf bank_mask:0xf
    v_and_b32_dpp v116, v11, v28 quad_perm:[1,1,1,1] row_mask:0xf bank_mask:0xf
    v_and_b32_dpp v117, v11, v29 quad_perm:[1,1,1,1] row_mask:0xf bank_mask:0xf
    s_waitcnt vmcnt(11)
    s_nop 0
    v_mfma_f32_16x16x32_bf16 v[118:121], v[114:117], v[66:69], v[118:121]
    v_and_b32_dpp v110, v12, v26 quad_perm:[1,1,1,1] row_mask:0xf bank_mask:0xf
    v_and_b32_dpp v111, v12, v27 quad_perm:[1,1,1,1] row_mask:0xf bank_mask:0xf
    v_and_b32_dpp v112, v12, v28 quad_perm:[1,1,1,1] row_mask:0xf bank_mask:0xf
    v_and_b32_dpp v113, v12, v29 quad_perm:[1,1,1,1] row_mask:0xf bank_mask:0xf
    s_waitcnt vmcnt(10)
    s_nop 0
    v_mfma_f32_16x16x32_bf16 v[118:121], v[110:113], v[70:73], v[118:121]
    v_and_b32_dpp v114, v13, v26 quad_perm:[1,1,1,1] row_mask:0xf bank_mask:0xf
    v_and_b32_dpp v115, v13, v27 quad_perm:[1,1,1,1] row_mask:0xf bank_mask:0xf
    v_and_b32_dpp v116, v13, v28 quad_perm:[1,1,1,1] row_mask:0xf bank_mask:0xf
    v_and_b32_dpp v117, v13, v29 quad_perm:[1,1,1,1] row_mask:0xf bank_mask:0xf
    s_waitcnt vmcnt(9)
    s_nop 0
    v_mfma_f32_16x16x32_bf16 v[118:121], v[114:117], v[74:77], v[118:121]
    v_and_b32_dpp v110, v10, v26 quad_perm:[2,2,2,2] row_mask:0xf bank_mask:0xf
    v_and_b32_dpp v111, v10, v27 quad_perm:[2,2,2,2] row_mask:0xf bank_mask:0xf
    v_and_b32_dpp v112, v10, v28 quad_perm:[2,2,2,2] row_mask:0xf bank_mask:0xf
    v_and_b32_dpp v113, v10, v29 quad_perm:[2,2,2,2] row_mask:0xf bank_mask:0xf
    s_waitcnt vmcnt(7)
    s_nop 0
    v_mfma_f32_16x16x32_bf16 v[118:121], v[110:113], v[78:81], v[118:121]
    v_and_b32_dpp v114, v11, v26 quad_perm:[2,2,2,2] row_mask:0xf bank_mask:0xf
    v_and_b32_dpp v115, v11, v27 quad_perm:[2,2,2,2] row_mask:0xf bank_mask:0xf
    v_and_b32_dpp v116, v11, v28 quad_perm:[2,2,2,2] row_mask:0xf bank_mask:0xf
    v_and_b32_dpp v117, v11, v29 quad_perm:[2,2,2,2] row_mask:0xf bank_mask:0xf
    s_waitcnt vmcnt(6)
    s_nop 0
    v_mfma_f32_16x16x32_bf16 v[118:121], v[114:117], v[82:85], v[118:121]
    v_and_b32_dpp v110, v12, v26 quad_perm:[2,2,2,2] row_mask:0xf bank_mask:0xf
    v_and_b32_dpp v111, v12, v27 quad_perm:[2,2,2,2] row_mask:0xf bank_mask:0xf
    v_and_b32_dpp v112, v12, v28 quad_perm:[2,2,2,2] row_mask:0xf bank_mask:0xf
    v_and_b32_dpp v113, v12, v29 quad_perm:[2,2,2,2] row_mask:0xf bank_mask:0xf
    s_waitcnt vmcnt(5)
    s_nop 0
    v_mfma_f32_16x16x32_bf16 v[118:121], v[110:113], v[86:89], v[118:121]
    v_and_b32_dpp v114, v13, v26 quad_perm:[2,2,2,2] row_mask:0xf bank_mask:0xf
    v_and_b32_dpp v115, v13, v27 quad_perm:[2,2,2,2] row_mask:0xf bank_mask:0xf
    v_and_b32_dpp v116, v13, v28 quad_perm:[2,2,2,2] row_mask:0xf bank_mask:0xf
    v_and_b32_dpp v117, v13, v29 quad_perm:[2,2,2,2] row_mask:0xf bank_mask:0xf
    s_waitcnt vmcnt(4)
    s_nop 0
    v_mfma_f32_16x16x32_bf16 v[118:121], v[114:117], v[90:93], v[118:121]
    v_and_b32_dpp v110, v10, v26 quad_perm:[3,3,3,3] row_mask:0xf bank_mask:0xf
    v_and_b32_dpp v111, v10, v27 quad_perm:[3,3,3,3] row_mask:0xf bank_mask:0xf
    v_and_b32_dpp v112, v10, v28 quad_perm:[3,3,3,3] row_mask:0xf bank_mask:0xf
    v_and_b32_dpp v113, v10, v29 quad_perm:[3,3,3,3] row_mask:0xf bank_mask:0xf
    s_waitcnt vmcnt(3)
    s_nop 0
    v_mfma_f32_16x16x32_bf16 v[118:121], v[110:113], v[94:97], v[118:121]
    v_and_b32_dpp v114, v11, v26 quad_perm:[3,3,3,3] row_mask:0xf bank_mask:0xf
    v_and_b32_dpp v115, v11, v27 quad_perm:[3,3,3,3] row_mask:0xf bank_mask:0xf
    v_and_b32_dpp v116, v11, v28 quad_perm:[3,3,3,3] row_mask:0xf bank_mask:0xf
    v_and_b32_dpp v117, v11, v29 quad_perm:[3,3,3,3] row_mask:0xf bank_mask:0xf
    s_waitcnt vmcnt(2)
    s_nop 0
    v_mfma_f32_16x16x32_bf16 v[118:121], v[114:117], v[98:101], v[118:121]
    v_and_b32_dpp v110, v12, v26 quad_perm:[3,3,3,3] row_mask:0xf bank_mask:0xf
    v_and_b32_dpp v111, v12, v27 quad_perm:[3,3,3,3] row_mask:0xf bank_mask:0xf
    v_and_b32_dpp v112, v12, v28 quad_perm:[3,3,3,3] row_mask:0xf bank_mask:0xf
    v_and_b32_dpp v113, v12, v29 quad_perm:[3,3,3,3] row_mask:0xf bank_mask:0xf
    s_waitcnt lgkmcnt(0)
    s_mul_i32 s33, s33, 0x0019660d
    s_add_u32 s33, s33, 0x3c6ef35f
    s_bfe_u32 s36, s33, 0x80000
    s_bfe_u32 s37, s33, 0x80008
    s_bfe_u32 s38, s33, 0x80010
    s_bfe_u32 s39, s33, 0x80018
    s_getreg_b32 s42, hwreg(HW_REG_XCC_ID, 0, 4)
    s_lshl1_add_u32 s42, s42, 32
    s_xor_b32 s43, s36, s42
    s_waitcnt vmcnt(1)
    v_mfma_f32_16x16x32_bf16 v[118:121], v[110:113], v[102:105], v[118:121]
    v_and_b32_dpp v114, v13, v26 quad_perm:[3,3,3,3] row_mask:0xf bank_mask:0xf
    v_and_b32_dpp v115, v13, v27 quad_perm:[3,3,3,3] row_mask:0xf bank_mask:0xf
    v_and_b32_dpp v116, v13, v28 quad_perm:[3,3,3,3] row_mask:0xf bank_mask:0xf
    v_and_b32_dpp v117, v13, v29 quad_perm:[3,3,3,3] row_mask:0xf bank_mask:0xf
    s_waitcnt vmcnt(0)
    s_nop 0
    v_mfma_f32_16x16x32_bf16 v[118:121], v[114:117], v[106:109], v[118:121]
    s_nop 7
    v_mov_b64 v[2:3], v[118:119]
    v_mov_b64 v[4:5], v[120:121]
    s_nop 0
    v_permlane32_swap_b32 v118, v2
    v_permlane32_swap_b32 v119, v3
    v_permlane32_swap_b32 v120, v4
    v_permlane32_swap_b32 v121, v5
    v_add_f32_dpp v118, v2, v118 row_ror:8 row_mask:0xf bank_mask:0xf
    v_add_f32_dpp v119, v3, v119 row_ror:8 row_mask:0xf bank_mask:0xf
    v_add_f32_dpp v120, v4, v120 row_ror:8 row_mask:0xf bank_mask:0xf
    v_add_f32_dpp v121, v5, v121 row_ror:8 row_mask:0xf bank_mask:0xf
    v_and_or_b32 v118, v118, v33, s43
    v_and_or_b32 v119, v119, v33, s37
    v_and_or_b32 v120, v120, v33, s38
    v_and_or_b32 v121, v121, v33, s39
    s_mov_b64 exec, 0x00ff00ff
    global_store_dwordx4 v36, v[118:121], s[26:27]
    s_mov_b64 exec, -1
    s_barrier
    s_waitcnt vmcnt(0)
    global_load_dwordx4 v[122:125], v37, s[26:27] offset:-4096 sc1
    global_load_dwordx4 v[126:129], v37, s[26:27] offset:-3072 sc1
    global_load_dwordx4 v[130:133], v37, s[26:27] offset:-2048 sc1
    global_load_dwordx4 v[134:137], v37, s[26:27] offset:-1024 sc1
    global_load_dwordx4 v[138:141], v37, s[26:27] offset:0 sc1
    global_load_dwordx4 v[142:145], v37, s[26:27] offset:1024 sc1
    global_load_dwordx4 v[146:149], v37, s[26:27] offset:2048 sc1
    global_load_dwordx4 v[150:153], v37, s[26:27] offset:3072 sc1
    s_mov_b64 exec, 0xffff
    global_load_dword v38, v38, s[26:27] nt
    s_mov_b64 exec, -1
    v_lshlrev_b32 v8, 3, v0
    s_waitcnt vmcnt(1)
    s_mov_b32 s41, 0
L_q_chk:
    v_xor_b32 v122, s43, v122
    v_xor_b32 v123, s37, v123
    v_xor_b32 v124, s38, v124
    v_xor_b32 v125, s39, v125
    v_xor_b32 v126, s43, v126
    v_xor_b32 v127, s37, v127
    v_xor_b32 v128, s38, v128
    v_xor_b32 v129, s39, v129
    v_xor_b32 v130, s43, v130
    v_xor_b32 v131, s37, v131
    v_xor_b32 v132, s38, v132
    v_xor_b32 v133, s39, v133
    v_xor_b32 v134, s43, v134
    v_xor_b32 v135, s37, v135
    v_xor_b32 v136, s38, v136
    v_xor_b32 v137, s39, v137
    v_xor_b32 v138, s43, v138
    v_xor_b32 v139, s37, v139
    v_xor_b32 v140, s38, v140
    v_xor_b32 v141, s39, v141
    v_xor_b32 v142, s43, v142
    v_xor_b32 v143, s37, v143
    v_xor_b32 v144, s38, v144
    v_xor_b32 v145, s39, v145
    v_xor_b32 v146, s43, v146
    v_xor_b32 v147, s37, v147
    v_xor_b32 v148, s38, v148
    v_xor_b32 v149, s39, v149
    v_xor_b32 v150, s43, v150
    v_xor_b32 v151, s37, v151
    v_xor_b32 v152, s38, v152
    v_xor_b32 v153, s39, v153
    v_or3_b32 v2, v122, v123, v124
    v_or3_b32 v2, v2, v125, v126
    v_or3_b32 v2, v2, v127, v128
    v_or3_b32 v2, v2, v129, v130
    v_or3_b32 v2, v2, v131, v132
    v_or3_b32 v2, v2, v133, v134
    v_or3_b32 v2, v2, v135, v136
    v_or3_b32 v2, v2, v137, v138
    v_or3_b32 v2, v2, v139, v140
    v_or3_b32 v2, v2, v141, v142
    v_or3_b32 v2, v2, v143, v144
    v_or3_b32 v2, v2, v145, v146
    v_or3_b32 v2, v2, v147, v148
    v_or3_b32 v2, v2, v149, v150
    v_or3_b32 v2, v2, v151, v152
    v_or_b32 v2, v2, v153
    v_cmp_ne_u32_sdwa vcc, v2, 0 src0_sel:BYTE_0 src1_sel:DWORD
    s_nop 0
    s_and_b64 exec, exec, vcc
    s_cbranch_scc1 L_q_re
L_q_ok:
    s_mov_b64 exec, -1
    v_pk_add_f32 v[122:123], v[122:123], v[130:131]
    v_pk_add_f32 v[124:125], v[124:125], v[132:133]
    v_pk_add_f32 v[138:139], v[138:139], v[146:147]
    v_pk_add_f32 v[140:141], v[140:141], v[148:149]
    v_pk_add_f32 v[126:127], v[126:127], v[134:135]
    v_pk_add_f32 v[128:129], v[128:129], v[136:137]
    v_pk_add_f32 v[142:143], v[142:143], v[150:151]
    v_pk_add_f32 v[144:145], v[144:145], v[152:153]
    v_pk_add_f32 v[122:123], v[122:123], v[138:139]
    v_pk_add_f32 v[124:125], v[124:125], v[140:141]
    v_pk_add_f32 v[126:127], v[126:127], v[142:143]
    v_pk_add_f32 v[128:129], v[128:129], v[144:145]
    v_cvt_pk_bf16_f32 v2, v122, v123
    v_cvt_pk_bf16_f32 v3, v124, v125
    v_cvt_pk_bf16_f32 v4, v126, v127
    v_cvt_pk_bf16_f32 v5, v128, v129
    v_mov_b32 v6, s44
    ds_write2st64_b64 v8, v[2:3], v[4:5] offset0:0 offset1:1
    ds_write_b32 v8, v6 offset:1280
    s_waitcnt lgkmcnt(0)
    s_barrier
    s_endpgm
L_A1:
    v_and_b32 v3, 1, v0
    v_lshlrev_b32 v3, 4, v3
    v_mov_b32 v4, 0xffff
    v_lshlrev_b32 v3, v3, v4
    v_lshrrev_b32 v4, 1, v31
    v_cmp_eq_u32 s[48:49], 0, v4
    v_cmp_eq_u32 s[50:51], 1, v4
    v_cmp_eq_u32 s[30:31], 2, v4
    v_cmp_eq_u32 s[34:35], 3, v4
    v_cndmask_b32 v26, 0, v3, s[48:49]
    v_cndmask_b32 v27, 0, v3, s[50:51]
    v_cndmask_b32 v28, 0, v3, s[30:31]
    v_cndmask_b32 v29, 0, v3, s[34:35]
    v_mov_b32 v33, 0xffffff00
    v_or_b32 v52, v26, v28
    v_or_b32 v53, v27, v29
    s_mov_b32 s48, 0xaaaaaaaa
    s_mov_b32 s49, s48
    s_mov_b32 s50, 0xcccccccc
    s_mov_b32 s51, s50
    v_and_b32 v8, 15, v0
    v_lshlrev_b32 v7, 4, v8
    s_lshr_b32 s14, s29, 2
    s_lshl3_add_u32 s15, s28, s14
    s_lshl2_add_u32 s30, s15, s3
    s_lshl_b32 s30, s30, 14
    s_and_b32 s32, s29, 3
    s_lshl_b32 s31, s32, 8
    s_add_u32 s30, s30, s31
    s_add_u32 s30, s30, 4096
    v_lshl_add_u32 v39, v1, 10, v7
    v_add_u32 v39, s30, v39
    v_add_u32 v40, 0x2000, v39
    s_lshl_b32 s32, s32, 16
    s_lshl_b32 s15, s15, 10
    s_add_u32 s15, s15, s32
    s_add_u32 s15, s15, 1048576
    v_add_u32 v44, s15, v34
    v_lshlrev_b32 v46, 5, v6
    s_lshl_b32 s32, s3, 11
    v_add_u32 v47, s32, v34
    v_and_b32 v4, 1, v0
    v_lshrrev_b32 v5, 1, v0
    s_lshl_b32 s32, s3, 8
    v_lshl_add_u32 v48, v5, 4, s32
    v_lshl_add_u32 v48, v4, 10, v48
    s_lshl_b32 s32, s3, 9
    v_add_u32 v49, s32, v34
    s_lshl_b32 s30, s28, 16
    s_add_u32 s30, s30, 524288
    s_lshl_b32 s31, s47, 9
    s_add_u32 s31, s31, s30
    v_add_u32 v43, s31, v34
    s_lshl2_add_u32 s31, s14, s3
    s_lshl_b32 s31, s31, 6
    s_add_u32 s30, s30, s31
    v_lshrrev_b32 v4, 2, v0
    v_lshl_add_u32 v41, v4, 11, v9
    v_add_u32 v41, s30, v41
    v_add_u32 v42, 0x8000, v41
    s_lshl_b32 s30, s29, 7
    s_lshl2_add_u32 s30, s28, s30
    s_add_u32 s30, s30, 1310720
    v_lshl_add_u32 v50, v0, 12, s30
    v_lshlrev_b32 v30, 3, v0
    s_cmp_eq_u32 s3, 3
    s_cselect_b32 s46, 1, 0
    s_waitcnt lgkmcnt(0)
    s_mul_i32 s33, s33, 0x0019660d
    s_add_u32 s33, s33, 0x3c6ef35f
    s_bfe_u32 s36, s33, 0x80000
    s_bfe_u32 s37, s33, 0x80008
    s_bfe_u32 s38, s33, 0x80010
    s_bfe_u32 s39, s33, 0x80018
    v_mov_b32 v153, s33
    v_mov_b32 v9, 0
    s_barrier
    global_load_dwordx4 v[66:69], v35, s[6:7] offset:2048 nt
    s_barrier
    global_load_dwordx4 v[70:73], v35, s[6:7] offset:3072 nt
    s_waitcnt vmcnt(3)
    global_load_dwordx4 v[74:77], v36, s[6:7] offset:0 nt
    global_load_dwordx4 v[78:81], v36, s[6:7] offset:1024 nt
    s_waitcnt vmcnt(4)
    global_load_dwordx4 v[82:85], v36, s[6:7] offset:2048 nt
    s_waitcnt vmcnt(4)
    global_load_dwordx4 v[86:89], v36, s[6:7] offset:3072 nt
    s_waitcnt vmcnt(4)
    global_load_dwordx4 v[90:93], v37, s[8:9] offset:0 nt
    s_waitcnt vmcnt(4)
    global_load_dwordx4 v[94:97], v37, s[8:9] offset:1024 nt
    s_waitcnt vmcnt(4)
    global_load_dwordx4 v[98:101], v37, s[8:9] offset:2048 nt
    s_waitcnt vmcnt(4)
    global_load_dwordx4 v[102:105], v37, s[8:9] offset:3072 nt
    s_waitcnt vmcnt(4)
    global_load_dwordx4 v[106:109], v38, s[8:9] offset:0 nt
    s_barrier
    ds_read_b128 v[138:141], v45 offset:0
    ds_read_b32 v9, v9 offset:1280
    global_load_dwordx4 v[110:113], v38, s[8:9] offset:1024 nt
    s_waitcnt lgkmcnt(1)
    v_mfma_f32_16x16x32_bf16 v[54:57], v[58:61], v[138:141], 0
    v_mfma_f32_16x16x32_bf16 v[58:61], v[62:65], v[138:141], 0
    v_mfma_f32_16x16x32_bf16 v[62:65], v[66:69], v[138:141], 0
    v_mfma_f32_16x16x32_bf16 v[66:69], v[70:73], v[138:141], 0
    v_mfma_f32_16x16x32_bf16 v[70:73], v[74:77], v[138:141], 0
    v_mfma_f32_16x16x32_bf16 v[74:77], v[78:81], v[138:141], 0
    v_mfma_f32_16x16x32_bf16 v[78:81], v[82:85], v[138:141], 0
    v_mfma_f32_16x16x32_bf16 v[82:85], v[86:89], v[138:141], 0
    s_waitcnt lgkmcnt(0)
    v_readfirstlane_b32 s44, v9
    v_mov_b32_dpp v10, v54 quad_perm:[0,0,0,0] row_mask:0xf bank_mask:0xf
    v_mov_b32_dpp v11, v58 quad_perm:[0,0,0,0] row_mask:0xf bank_mask:0xf
    v_mov_b32_dpp v12, v62 quad_perm:[0,0,0,0] row_mask:0xf bank_mask:0xf
    v_mov_b32_dpp v13, v66 quad_perm:[0,0,0,0] row_mask:0xf bank_mask:0xf
    v_mov_b32_dpp v14, v70 quad_perm:[0,0,0,0] row_mask:0xf bank_mask:0xf
    v_mov_b32_dpp v15, v74 quad_perm:[0,0,0,0] row_mask:0xf bank_mask:0xf
    v_mov_b32_dpp v16, v78 quad_perm:[0,0,0,0] row_mask:0xf bank_mask:0xf
    v_mov_b32_dpp v17, v82 quad_perm:[0,0,0,0] row_mask:0xf bank_mask:0xf
    v_add_f32_dpp v10, v55, v10 quad_perm:[1,1,1,1] row_mask:0xf bank_mask:0xf
    v_add_f32_dpp v11, v59, v11 quad_perm:[1,1,1,1] row_mask:0xf bank_mask:0xf
    v_add_f32_dpp v12, v63, v12 quad_perm:[1,1,1,1] row_mask:0xf bank_mask:0xf
    v_add_f32_dpp v13, v67, v13 quad_perm:[1,1,1,1] row_mask:0xf bank_mask:0xf
    v_add_f32_dpp v14, v71, v14 quad_perm:[1,1,1,1] row_mask:0xf bank_mask:0xf
    v_add_f32_dpp v15, v75, v15 quad_perm:[1,1,1,1] row_mask:0xf bank_mask:0xf
    v_add_f32_dpp v16, v79, v16 quad_perm:[1,1,1,1] row_mask:0xf bank_mask:0xf
    v_add_f32_dpp v17, v83, v17 quad_perm:[1,1,1,1] row_mask:0xf bank_mask:0xf
    v_add_f32_dpp v10, v56, v10 quad_perm:[2,2,2,2] row_mask:0xf bank_mask:0xf
    v_add_f32_dpp v11, v60, v11 quad_perm:[2,2,2,2] row_mask:0xf bank_mask:0xf
    v_add_f32_dpp v12, v64, v12 quad_perm:[2,2,2,2] row_mask:0xf bank_mask:0xf
    v_add_f32_dpp v13, v68, v13 quad_perm:[2,2,2,2] row_mask:0xf bank_mask:0xf
    v_add_f32_dpp v14, v72, v14 quad_perm:[2,2,2,2] row_mask:0xf bank_mask:0xf
    v_add_f32_dpp v15, v76, v15 quad_perm:[2,2,2,2] row_mask:0xf bank_mask:0xf
    v_add_f32_dpp v16, v80, v16 quad_perm:[2,2,2,2] row_mask:0xf bank_mask:0xf
    v_add_f32_dpp v17, v84, v17 quad_perm:[2,2,2,2] row_mask:0xf bank_mask:0xf
    v_add_f32_dpp v10, v57, v10 quad_perm:[3,3,3,3] row_mask:0xf bank_mask:0xf
    v_add_f32_dpp v11, v61, v11 quad_perm:[3,3,3,3] row_mask:0xf bank_mask:0xf
    v_add_f32_dpp v12, v65, v12 quad_perm:[3,3,3,3] row_mask:0xf bank_mask:0xf
    v_add_f32_dpp v13, v69, v13 quad_perm:[3,3,3,3] row_mask:0xf bank_mask:0xf
    v_add_f32_dpp v14, v73, v14 quad_perm:[3,3,3,3] row_mask:0xf bank_mask:0xf
    v_add_f32_dpp v15, v77, v15 quad_perm:[3,3,3,3] row_mask:0xf bank_mask:0xf
    v_add_f32_dpp v16, v81, v16 quad_perm:[3,3,3,3] row_mask:0xf bank_mask:0xf
    v_add_f32_dpp v17, v85, v17 quad_perm:[3,3,3,3] row_mask:0xf bank_mask:0xf
    global_load_dwordx4 v[114:117], v38, s[8:9] offset:2048 nt
    v_cndmask_b32 v10, v10, v11, s[48:49]
    v_cndmask_b32 v12, v12, v13, s[48:49]
    v_cndmask_b32 v14, v14, v15, s[48:49]
    v_cndmask_b32 v16, v16, v17, s[48:49]
    v_cndmask_b32 v10, v10, v12, s[50:51]
    v_cndmask_b32 v11, v14, v16, s[50:51]
    v_cvt_pk_bf16_f32 v2, v10, v11
    v_lshlrev_b32 v10, 16, v2
    v_and_b32 v11, 0xffff0000, v2
    v_mul_f32 v10, 0x3db504f3, v10
    v_mul_f32 v11, 0x3db504f3, v11
    v_cvt_pk_bf16_f32 v2, v10, v11
    v_lshlrev_b32 v10, 16, v2
    v_and_b32 v11, 0xffff0000, v2
    v_max_f32 v2, v10, v11
    s_nop 1
    v_max_f32_dpp v2, v2, v2 quad_perm:[1,0,3,2] row_mask:0xf bank_mask:0xf
    s_nop 1
    v_max_f32_dpp v2, v2, v2 quad_perm:[2,3,0,1] row_mask:0xf bank_mask:0xf
    v_mov_b32 v3, v2
    s_nop 1
    v_permlane16_swap_b32 v2, v3
    v_max_f32 v2, v2, v3
    v_mov_b32 v3, v2
    s_nop 1
    v_permlane32_swap_b32 v2, v3
    v_max_f32 v2, v2, v3
    v_sub_f32 v10, v10, v2
    v_sub_f32 v11, v11, v2
    v_mul_f32 v10, 0x3fb8aa3b, v10
    v_mul_f32 v11, 0x3fb8aa3b, v11
    v_mul_f32 v2, 0x3fb8aa3b, v2
    v_exp_f32 v10, v10
    v_exp_f32 v11, v11
    s_lshl_b32 s30, s3, 3
    v_add_u32 v6, s30, v46
    v_add_f32 v3, v10, v11
    s_nop 1
    v_add_f32_dpp v3, v3, v3 quad_perm:[1,0,3,2] row_mask:0xf bank_mask:0xf
    s_nop 1
    v_add_f32_dpp v3, v3, v3 quad_perm:[2,3,0,1] row_mask:0xf bank_mask:0xf
    v_mov_b32 v4, v3
    s_nop 1
    v_permlane16_swap_b32 v3, v4
    v_add_f32 v3, v3, v4
    v_mov_b32 v4, v3
    s_nop 1
    v_permlane32_swap_b32 v3, v4
    v_add_f32 v3, v3, v4
    ds_write_b64 v6, v[2:3] offset:1024
    global_load_dwordx4 v[118:121], v38, s[8:9] offset:3072 nt
    s_waitcnt lgkmcnt(0)
    s_barrier
    ds_read_b128 v[18:21], v46 offset:1024
    ds_read_b128 v[22:25], v46 offset:1040
    s_lshl_b32 s30, s3, 2
    s_waitcnt lgkmcnt(0)
    v_max3_f32 v4, v18, v20, v22
    v_max_f32 v4, v4, v24
    v_sub_f32 v18, v18, v4
    v_sub_f32 v20, v20, v4
    v_sub_f32 v22, v22, v4
    v_sub_f32 v24, v24, v4
    v_sub_f32 v2, v2, v4
    v_exp_f32 v18, v18
    v_exp_f32 v20, v20
    v_exp_f32 v22, v22
    v_exp_f32 v24, v24
    v_exp_f32 v2, v2
    v_mul_f32 v3, v18, v19
    v_fmac_f32 v3, v20, v21
    v_fmac_f32 v3, v22, v23
    v_fmac_f32 v3, v24, v25
    v_rcp_f32 v6, v3
    v_log_f32 v3, v3
    v_mul_f32 v2, v2, v6
    v_add_f32 v3, v3, v4
    v_mul_f32 v10, v10, v2
    v_mul_f32 v11, v11, v2
    v_readlane_b32 s40, v3, s30
    v_cvt_pk_bf16_f32 v10, v10, v10
    v_cvt_pk_bf16_f32 v11, v11, v11
    v_mov_b32 v152, s40
    v_and_b32_dpp v58, v10, v52 quad_perm:[0,0,0,0] row_mask:0xf bank_mask:0xf
    v_and_b32_dpp v59, v10, v53 quad_perm:[0,0,0,0] row_mask:0xf bank_mask:0xf
    v_and_b32_dpp v60, v10, v52 quad_perm:[1,1,1,1] row_mask:0xf bank_mask:0xf
    v_and_b32_dpp v61, v10, v53 quad_perm:[1,1,1,1] row_mask:0xf bank_mask:0xf
    s_waitcnt vmcnt(7)
    v_mfma_f32_16x16x16_bf16 v[142:145], v[58:59], v[90:91], 0
    v_mfma_f32_16x16x16_bf16 v[146:149], v[58:59], v[92:93], 0
    v_and_b32_dpp v62, v10, v52 quad_perm:[2,2,2,2] row_mask:0xf bank_mask:0xf
    v_and_b32_dpp v63, v10, v53 quad_perm:[2,2,2,2] row_mask:0xf bank_mask:0xf
    s_waitcnt vmcnt(6)
    v_mfma_f32_16x16x16_bf16 v[142:145], v[60:61], v[94:95], v[142:145]
    v_mfma_f32_16x16x16_bf16 v[146:149], v[60:61], v[96:97], v[146:149]
    v_and_b32_dpp v64, v10, v52 quad_perm:[3,3,3,3] row_mask:0xf bank_mask:0xf
    v_and_b32_dpp v65, v10, v53 quad_perm:[3,3,3,3] row_mask:0xf bank_mask:0xf
    s_waitcnt vmcnt(5)
    v_mfma_f32_16x16x16_bf16 v[142:145], v[62:63], v[98:99], v[142:145]
    v_mfma_f32_16x16x16_bf16 v[146:149], v[62:63], v[100:101], v[146:149]
    v_and_b32_dpp v66, v11, v52 quad_perm:[0,0,0,0] row_mask:0xf bank_mask:0xf
    v_and_b32_dpp v67, v11, v53 quad_perm:[0,0,0,0] row_mask:0xf bank_mask:0xf
    s_waitcnt vmcnt(4)
    v_mfma_f32_16x16x16_bf16 v[142:145], v[64:65], v[102:103], v[142:145]
    v_mfma_f32_16x16x16_bf16 v[146:149], v[64:65], v[104:105], v[146:149]
    v_and_b32_dpp v68, v11, v52 quad_perm:[1,1,1,1] row_mask:0xf bank_mask:0xf
    v_and_b32_dpp v69, v11, v53 quad_perm:[1,1,1,1] row_mask:0xf bank_mask:0xf
    s_waitcnt vmcnt(3)
    v_mfma_f32_16x16x16_bf16 v[142:145], v[66:67], v[106:107], v[142:145]
    v_mfma_f32_16x16x16_bf16 v[146:149], v[66:67], v[108:109], v[146:149]
    v_and_b32_dpp v70, v11, v52 quad_perm:[2,2,2,2] row_mask:0xf bank_mask:0xf
    v_and_b32_dpp v71, v11, v53 quad_perm:[2,2,2,2] row_mask:0xf bank_mask:0xf
    s_waitcnt vmcnt(2)
    global_load_dwordx4 v[122:125], v39, s[12:13] offset:-4096 nt
    v_mfma_f32_16x16x16_bf16 v[142:145], v[68:69], v[110:111], v[142:145]
    v_mfma_f32_16x16x16_bf16 v[146:149], v[68:69], v[112:113], v[146:149]
    v_and_b32_dpp v72, v11, v52 quad_perm:[3,3,3,3] row_mask:0xf bank_mask:0xf
    v_and_b32_dpp v73, v11, v53 quad_perm:[3,3,3,3] row_mask:0xf bank_mask:0xf
    s_waitcnt vmcnt(2)
    global_load_dwordx4 v[126:129], v39, s[12:13] offset:0 nt
    v_mfma_f32_16x16x16_bf16 v[142:145], v[70:71], v[114:115], v[142:145]
    v_mfma_f32_16x16x16_bf16 v[146:149], v[70:71], v[116:117], v[146:149]
    global_load_dwordx4 v[130:133], v40, s[12:13] offset:-4096 nt
    global_load_dwordx4 v[134:137], v40, s[12:13] offset:0 nt
    s_cmp_lg_u32 s44, 0
    s_waitcnt vmcnt(4)
    v_mfma_f32_16x16x16_bf16 v[142:145], v[72:73], v[118:119], v[142:145]
    v_mfma_f32_16x16x16_bf16 v[146:149], v[72:73], v[120:121], v[146:149]
    s_nop 6
    ds_write_b128 v47, v[142:145] offset:2048
    ds_write_b128 v47, v[146:149] offset:3072
    s_mov_b32 exec_hi, 0
    s_waitcnt lgkmcnt(0)
    s_barrier
    ds_read_b128 v[10:13], v48 offset:2048
    ds_read_b128 v[14:17], v48 offset:4096
    ds_read_b128 v[18:21], v48 offset:6144
    ds_read_b128 v[22:25], v48 offset:8192
    s_waitcnt lgkmcnt(2)
    v_pk_add_f32 v[10:11], v[10:11], v[14:15]
    v_pk_add_f32 v[12:13], v[12:13], v[16:17]
    s_waitcnt lgkmcnt(1)
    v_pk_add_f32 v[10:11], v[10:11], v[18:19]
    v_pk_add_f32 v[12:13], v[12:13], v[20:21]
    s_waitcnt lgkmcnt(0)
    v_pk_add_f32 v[10:11], v[10:11], v[22:23]
    v_pk_add_f32 v[12:13], v[12:13], v[24:25]
    v_cvt_pk_bf16_f32 v150, v10, v11
    v_cvt_pk_bf16_f32 v151, v12, v13
    s_cbranch_scc1 L_oslow
    global_store_dwordx4 v43, v[150:153], s[26:27]
L_opub:
    s_mov_b64 exec, -1
    s_mov_b32 s41, 100000
L_o:
    global_load_dwordx4 v[74:77], v41, s[26:27] sc1
    global_load_dwordx4 v[78:81], v42, s[26:27] sc1
L_o_w:
    s_sub_u32 s41, s41, 1
    s_cselect_b64 s[34:35], 0, exec
    s_waitcnt vmcnt(0)
    v_cmp_ne_u32 vcc, s33, v77
    v_cmp_ne_u32 s[30:31], s33, v81
    s_nop 0
    s_or_b64 vcc, vcc, s[30:31]
    s_and_b64 exec, s[34:35], vcc
    s_cbranch_scc1 L_o
    s_mov_b64 exec, -1
    v_max_f32 v2, v76, v80
    v_lshlrev_b32 v10, 16, v74
    v_and_b32 v11, 0xffff0000, v74
    v_max_f32_dpp v2, v2, v2 row_ror:4 row_mask:0xf bank_mask:0xf
    v_lshlrev_b32 v12, 16, v75
    v_and_b32 v13, 0xffff0000, v75
    v_max_f32_dpp v2, v2, v2 row_ror:8 row_mask:0xf bank_mask:0xf
    v_mov_b32 v3, v2
    v_lshlrev_b32 v14, 16, v78
    v_and_b32 v15, 0xffff0000, v78
    v_permlane16_swap_b32 v2, v3
    v_max_f32 v2, v2, v3
    v_mov_b32 v3, v2
    v_lshlrev_b32 v16, 16, v79
    v_and_b32 v17, 0xffff0000, v79
    v_permlane32_swap_b32 v2, v3
    v_max_f32 v2, v2, v3
    v_sub_f32 v4, v76, v2
    v_sub_f32 v6, v80, v2
    v_exp_f32 v4, v4
    v_exp_f32 v6, v6
    v_pk_mul_f32 v[10:11], v[10:11], v[4:5] op_sel_hi:[1,0]
    v_pk_mul_f32 v[12:13], v[12:13], v[4:5] op_sel_hi:[1,0]
    v_add_f32 v2, v4, v6
    v_add_f32 v3, v4, v6
    v_pk_fma_f32 v[10:11], v[14:15], v[6:7], v[10:11] op_sel_hi:[1,0,1]
    v_pk_fma_f32 v[12:13], v[16:17], v[6:7], v[12:13] op_sel_hi:[1,0,1]
    v_permlane32_swap_b32 v2, v3
    v_add_f32 v4, v2, v3
    v_add_f32 v5, v2, v3
    v_permlane32_swap_b32 v10, v12
    v_permlane32_swap_b32 v11, v13
    v_pk_add_f32 v[10:11], v[10:11], v[12:13]
    v_permlane16_swap_b32 v4, v5
    v_add_f32 v4, v4, v5
    v_permlane16_swap_b32 v10, v11
    v_add_f32 v10, v10, v11
    v_add_f32_dpp v4, v4, v4 row_ror:4 row_mask:0xf bank_mask:0xf
    s_nop 0
    v_add_f32_dpp v10, v10, v10 row_ror:4 row_mask:0xf bank_mask:0xf
    v_add_f32_dpp v4, v4, v4 row_ror:8 row_mask:0xf bank_mask:0xf
    s_nop 0
    v_add_f32_dpp v10, v10, v10 row_ror:8 row_mask:0xf bank_mask:0xf
    v_rcp_f32 v4, v4
    s_nop 0
    v_mul_f32 v10, v10, v4
    v_cvt_pk_bf16_f32 v10, v10, v10
    s_nop 1
    v_and_b32_dpp v58, v10, v26 quad_perm:[0,0,0,0] row_mask:0xf bank_mask:0xf
    v_and_b32_dpp v59, v10, v27 quad_perm:[0,0,0,0] row_mask:0xf bank_mask:0xf
    v_and_b32_dpp v60, v10, v28 quad_perm:[0,0,0,0] row_mask:0xf bank_mask:0xf
    v_and_b32_dpp v61, v10, v29 quad_perm:[0,0,0,0] row_mask:0xf bank_mask:0xf
    v_and_b32_dpp v62, v10, v26 quad_perm:[1,1,1,1] row_mask:0xf bank_mask:0xf
    v_and_b32_dpp v63, v10, v27 quad_perm:[1,1,1,1] row_mask:0xf bank_mask:0xf
    v_and_b32_dpp v64, v10, v28 quad_perm:[1,1,1,1] row_mask:0xf bank_mask:0xf
    v_and_b32_dpp v65, v10, v29 quad_perm:[1,1,1,1] row_mask:0xf bank_mask:0xf
    v_mfma_f32_16x16x32_bf16 v[142:145], v[58:61], v[122:125], 0
    v_and_b32_dpp v66, v10, v26 quad_perm:[2,2,2,2] row_mask:0xf bank_mask:0xf
    v_and_b32_dpp v67, v10, v27 quad_perm:[2,2,2,2] row_mask:0xf bank_mask:0xf
    v_and_b32_dpp v68, v10, v28 quad_perm:[2,2,2,2] row_mask:0xf bank_mask:0xf
    v_and_b32_dpp v69, v10, v29 quad_perm:[2,2,2,2] row_mask:0xf bank_mask:0xf
    v_mfma_f32_16x16x32_bf16 v[142:145], v[62:65], v[126:129], v[142:145]
    v_and_b32_dpp v70, v10, v26 quad_perm:[3,3,3,3] row_mask:0xf bank_mask:0xf
    v_and_b32_dpp v71, v10, v27 quad_perm:[3,3,3,3] row_mask:0xf bank_mask:0xf
    v_and_b32_dpp v72, v10, v28 quad_perm:[3,3,3,3] row_mask:0xf bank_mask:0xf
    v_and_b32_dpp v73, v10, v29 quad_perm:[3,3,3,3] row_mask:0xf bank_mask:0xf
    v_mfma_f32_16x16x32_bf16 v[142:145], v[66:69], v[130:133], v[142:145]
    s_nop 0
    v_mfma_f32_16x16x32_bf16 v[142:145], v[70:73], v[134:137], v[142:145]
    s_cmp_lg_u32 s3, 0
    s_mov_b32 exec_hi, 0
    s_nop 5
    ds_write_b128 v49, v[142:145] offset:10240
    s_waitcnt lgkmcnt(0)
    s_barrier
    s_cbranch_scc1 L_nopub
    s_mov_b64 exec, -1
    ds_read2st64_b64 v[10:13], v30 offset0:20 offset1:21
    ds_read2st64_b64 v[14:17], v30 offset0:22 offset1:23
    ds_read_b64 v[144:145], v30 offset:12288
    s_waitcnt lgkmcnt(2)
    v_pk_add_f32 v[10:11], v[10:11], v[12:13]
    s_waitcnt lgkmcnt(1)
    v_pk_add_f32 v[14:15], v[14:15], v[16:17]
    v_pk_add_f32 v[142:143], v[10:11], v[14:15]
    s_waitcnt lgkmcnt(0)
    v_and_or_b32 v142, v142, v33, s36
    v_and_or_b32 v143, v143, v33, s37
    v_and_or_b32 v144, v144, v33, s38
    v_and_or_b32 v145, v145, v33, s39
    global_store_dwordx4 v44, v[142:145], s[26:27] sc1
    s_branch L_nopub2
L_nopub:
    s_cmp_eq_u32 s46, 0
    s_cbranch_scc1 L_nopub2
    s_mov_b64 exec, 255
    global_atomic_swap v50, v153, s[26:27]
L_nopub2:
    s_endpgm
L_F1:
    s_mov_b32 s15, s34
    v_and_b32 v3, 1, v0
    v_lshlrev_b32 v3, 4, v3
    v_mov_b32 v4, 0xffff
    v_lshlrev_b32 v3, v3, v4
    v_lshrrev_b32 v4, 1, v31
    v_cmp_eq_u32 s[48:49], 0, v4
    v_cmp_eq_u32 s[50:51], 1, v4
    v_cmp_eq_u32 s[30:31], 2, v4
    v_cmp_eq_u32 s[34:35], 3, v4
    v_cndmask_b32 v26, 0, v3, s[48:49]
    v_cndmask_b32 v27, 0, v3, s[50:51]
    v_cndmask_b32 v28, 0, v3, s[30:31]
    v_cndmask_b32 v29, 0, v3, s[34:35]
    v_mov_b32 v33, 0xffffff00
    v_and_b32 v3, 1, v1
    v_lshl_add_u32 v5, v31, 1, v3
    v_lshl_add_u32 v37, v5, 4, s15
    v_lshrrev_b32 v4, 5, v0
    v_lshl_add_u32 v37, v4, 8, v37
    s_lshr_b32 s14, s40, 2
    s_lshl_b32 s30, s47, 12
    s_lshl_b32 s31, s14, 7
    s_add_u32 s30, s30, s31
    s_add_u32 s30, s30, 262144
    v_lshl_add_u32 v38, v31, 4, s30
    v_lshl_add_u32 v38, v30, 9, v38
    s_lshl1_add_u32 s14, s47, s14
    s_and_b32 s15, s40, 3
    s_lshl_b32 s30, s14, 15
    s_lshl_b32 s31, s15, 8
    s_add_u32 s30, s30, s31
    s_add_u32 s30, s30, 4096
    v_and_b32 v4, 15, v0
    v_lshl_add_u32 v36, v4, 4, s30
    v_lshl_add_u32 v36, v1, 10, v36
    s_lshl_b32 s45, s28, 5
    s_add_u32 s45, s45, s29
    s_lshr_b32 s14, s28, 1
    s_lshl_b32 s30, s14, 16
    s_and_b32 s31, s45, 63
    s_lshl4_add_u32 s30, s31, s30
    s_add_u32 s30, s30, 1048576
    v_lshl_add_u32 v40, v0, 10, s30
    s_lshr_b32 s30, s29, 1
    s_lshl4_add_u32 s30, s14, s30
    s_and_b32 s31, s28, 1
    s_lshl1_add_u32 s30, s30, s31
    s_and_b32 s31, s29, 1
    s_lshl1_add_u32 s30, s30, s31
    s_lshl_b32 s30, s30, 2
    v_and_b32 v30, 1, v1
    v_lshl_add_u32 v30, v30, 1, s30
    v_mov_b32 v42, 0
    s_lshl_b32 s30, s45, 7
    s_add_u32 s30, s30, 1310720
    s_add_u32 s24, s26, s30
    s_addc_u32 s25, s27, 0
    s_waitcnt lgkmcnt(0)
    s_mul_i32 s33, s33, 0x0019660d
    s_add_u32 s33, s33, 0x3c6ef35f
    s_bfe_u32 s36, s33, 0x80000
    s_bfe_u32 s37, s33, 0x80008
    s_bfe_u32 s38, s33, 0x80010
    s_bfe_u32 s39, s33, 0x80018
    s_getreg_b32 s42, hwreg(HW_REG_XCC_ID, 0, 4)
    s_lshl1_add_u32 s42, s42, 32
    s_xor_b32 s43, s36, s42
    s_cmp_lg_u32 s28, 4
    s_cbranch_scc1 L_F2
    global_load_short_d16_hi v42, v30, s[4:5]
    v_mov_b64 v[156:157], 0
    v_mov_b64 v[158:159], 0
    s_barrier
    s_barrier
    s_barrier
    s_barrier
    s_barrier
    s_load_dwordx8 s[4:11], s[24:25], 0 glc
    s_branch L_ytag
L_F2:
    s_waitcnt vmcnt(5)
    v_readfirstlane_b32 s30, v44
    v_lshlrev_b32 v10, 16, v44
    v_and_b32 v11, 0xffff0000, v44
    v_lshlrev_b32 v12, 16, v45
    v_and_b32 v13, 0xffff0000, v45
    v_lshlrev_b32 v14, 16, v46
    v_and_b32 v15, 0xffff0000, v46
    v_lshlrev_b32 v16, 16, v47
    v_and_b32 v17, 0xffff0000, v47
    s_lshl_b32 s30, s30, 16
    s_mov_b32 s31, s30
    v_pk_add_f32 v[10:11], v[10:11], s[30:31] neg_lo:[0,1] neg_hi:[0,1]
    v_pk_add_f32 v[12:13], v[12:13], s[30:31] neg_lo:[0,1] neg_hi:[0,1]
    v_pk_add_f32 v[14:15], v[14:15], s[30:31] neg_lo:[0,1] neg_hi:[0,1]
    v_pk_add_f32 v[16:17], v[16:17], s[30:31] neg_lo:[0,1] neg_hi:[0,1]
    v_pk_add_f32 v[2:3], v[10:11], v[12:13]
    v_pk_mul_f32 v[4:5], v[10:11], v[10:11]
    v_pk_add_f32 v[2:3], v[2:3], v[14:15]
    v_pk_fma_f32 v[4:5], v[12:13], v[12:13], v[4:5]
    v_pk_add_f32 v[2:3], v[2:3], v[16:17]
    v_pk_fma_f32 v[4:5], v[14:15], v[14:15], v[4:5]
    v_pk_fma_f32 v[4:5], v[16:17], v[16:17], v[4:5]
    v_add_f32 v2, v2, v3
    v_add_f32 v3, v4, v5
    v_lshlrev_b32 v10, 16, v41
    v_add_f32_dpp v2, v2, v2 row_ror:8 row_mask:0xf bank_mask:0xf
    v_add_f32_dpp v3, v3, v3 row_ror:8 row_mask:0xf bank_mask:0xf
    v_and_b32 v11, 0xffff0000, v41
    v_add_f32_dpp v2, v2, v2 row_ror:4 row_mask:0xf bank_mask:0xf
    v_add_f32_dpp v3, v3, v3 row_ror:4 row_mask:0xf bank_mask:0xf
    s_nop 0
    v_add_f32_dpp v2, v2, v2 row_ror:2 row_mask:0xf bank_mask:0xf
    v_add_f32_dpp v3, v3, v3 row_ror:2 row_mask:0xf bank_mask:0xf
    s_nop 0
    v_add_f32_dpp v2, v2, v2 row_ror:1 row_mask:0xf bank_mask:0xf
    v_add_f32_dpp v3, v3, v3 row_ror:1 row_mask:0xf bank_mask:0xf
    v_mov_b32 v4, v2
    v_mov_b32 v5, v3
    s_nop 0
    v_permlane16_swap_b32 v2, v4
    v_permlane16_swap_b32 v3, v5
    v_add_f32 v2, v2, v4
    v_add_f32 v3, v3, v5
    v_mov_b32 v4, v2
    v_mov_b32 v5, v3
    s_nop 0
    v_permlane32_swap_b32 v2, v4
    v_permlane32_swap_b32 v3, v5
    v_add_f32 v2, v2, v4
    v_add_f32 v3, v3, v5
    v_mul_f32 v2, 0x3b000000, v2
    v_mul_f32 v3, 0x3b000000, v3
    v_fma_f32 v3, -v2, v2, v3
    v_add_f32 v2, s30, v2
    v_max_f32 v3, 0, v3
    v_cvt_pk_bf16_f32 v2, v2, v3
    v_and_b32 v4, 0xffff0000, v2
    v_lshlrev_b32 v2, 16, v2
    v_add_f32 v4, 0x3727c5ac, v4
    v_pk_add_f32 v[10:11], v[10:11], v[2:3] op_sel_hi:[1,0] neg_lo:[0,1] neg_hi:[0,1]
    v_cvt_pk_bf16_f32 v4, v4, v4
    v_lshlrev_b32 v4, 16, v4
    v_sqrt_f32 v4, v4
    v_cvt_pk_bf16_f32 v6, v10, v11
    v_cvt_pk_bf16_f32 v4, v4, v4
    v_lshlrev_b32 v4, 16, v4
    v_rcp_f32 v4, v4
    v_lshlrev_b32 v10, 16, v6
    v_and_b32 v11, 0xffff0000, v6
    v_pk_mul_f32 v[10:11], v[10:11], v[4:5] op_sel_hi:[1,0]
    s_nop 0
    v_cvt_pk_bf16_f32 v10, v10, v10
    v_cvt_pk_bf16_f32 v11, v11, v11
    s_barrier
    v_add_u32 v35, s32, v35
    global_load_dwordx4 v[64:67], v35, s[16:17] offset:0 nt
    global_load_dwordx4 v[68:71], v35, s[18:19] offset:0 nt
    s_barrier
    global_load_dwordx4 v[72:75], v35, s[16:17] offset:3584 nt
    global_load_dwordx4 v[76:79], v35, s[18:19] offset:3584 nt
    v_and_b32_dpp v144, v10, v26 quad_perm:[0,0,0,0] row_mask:0xf bank_mask:0xf
    v_and_b32_dpp v145, v10, v27 quad_perm:[0,0,0,0] row_mask:0xf bank_mask:0xf
    v_and_b32_dpp v146, v10, v28 quad_perm:[0,0,0,0] row_mask:0xf bank_mask:0xf
    v_and_b32_dpp v147, v10, v29 quad_perm:[0,0,0,0] row_mask:0xf bank_mask:0xf
    s_waitcnt vmcnt(8)
    v_add_u32 v35, s32, v35
    global_load_dwordx4 v[80:83], v35, s[16:17] offset:0 nt
    v_mfma_f32_16x16x32_bf16 v[152:155], v[144:147], v[48:51], 0
    s_waitcnt vmcnt(8)
    global_load_dwordx4 v[84:87], v35, s[18:19] offset:0 nt
    v_mfma_f32_16x16x32_bf16 v[156:159], v[144:147], v[52:55], 0
    v_and_b32_dpp v148, v11, v26 quad_perm:[0,0,0,0] row_mask:0xf bank_mask:0xf
    v_and_b32_dpp v149, v11, v27 quad_perm:[0,0,0,0] row_mask:0xf bank_mask:0xf
    v_and_b32_dpp v150, v11, v28 quad_perm:[0,0,0,0] row_mask:0xf bank_mask:0xf
    v_and_b32_dpp v151, v11, v29 quad_perm:[0,0,0,0] row_mask:0xf bank_mask:0xf
    s_waitcnt vmcnt(8)
    global_load_dwordx4 v[88:91], v35, s[16:17] offset:3584 nt
    v_mfma_f32_16x16x32_bf16 v[152:155], v[148:151], v[56:59], v[152:155]
    s_waitcnt vmcnt(8)
    global_load_dwordx4 v[92:95], v35, s[18:19] offset:3584 nt
    v_mfma_f32_16x16x32_bf16 v[156:159], v[148:151], v[60:63], v[156:159]
    v_and_b32_dpp v144, v10, v26 quad_perm:[1,1,1,1] row_mask:0xf bank_mask:0xf
    v_and_b32_dpp v145, v10, v27 quad_perm:[1,1,1,1] row_mask:0xf bank_mask:0xf
    v_and_b32_dpp v146, v10, v28 quad_perm:[1,1,1,1] row_mask:0xf bank_mask:0xf
    v_and_b32_dpp v147, v10, v29 quad_perm:[1,1,1,1] row_mask:0xf bank_mask:0xf
    s_waitcnt vmcnt(7)
    v_add_u32 v35, s32, v35
    global_load_dwordx4 v[96:99], v35, s[16:17] offset:0 nt
    v_mfma_f32_16x16x32_bf16 v[152:155], v[144:147], v[64:67], v[152:155]
    s_waitcnt vmcnt(7)
    global_load_dwordx4 v[100:103], v35, s[18:19] offset:0 nt
    v_mfma_f32_16x16x32_bf16 v[156:159], v[144:147], v[68:71], v[156:159]
    v_and_b32_dpp v148, v11, v26 quad_perm:[1,1,1,1] row_mask:0xf bank_mask:0xf
    v_and_b32_dpp v149, v11, v27 quad_perm:[1,1,1,1] row_mask:0xf bank_mask:0xf
    v_and_b32_dpp v150, v11, v28 quad_perm:[1,1,1,1] row_mask:0xf bank_mask:0xf
    v_and_b32_dpp v151, v11, v29 quad_perm:[1,1,1,1] row_mask:0xf bank_mask:0xf
    s_waitcnt vmcnt(7)
    global_load_dwordx4 v[104:107], v35, s[16:17] offset:3584 nt
    v_mfma_f32_16x16x32_bf16 v[152:155], v[148:151], v[72:75], v[152:155]
    s_waitcnt vmcnt(7)
    global_load_dwordx4 v[108:111], v35, s[18:19] offset:3584 nt
    v_mfma_f32_16x16x32_bf16 v[156:159], v[148:151], v[76:79], v[156:159]
    v_and_b32_dpp v144, v10, v26 quad_perm:[2,2,2,2] row_mask:0xf bank_mask:0xf
    v_and_b32_dpp v145, v10, v27 quad_perm:[2,2,2,2] row_mask:0xf bank_mask:0xf
    v_and_b32_dpp v146, v10, v28 quad_perm:[2,2,2,2] row_mask:0xf bank_mask:0xf
    v_and_b32_dpp v147, v10, v29 quad_perm:[2,2,2,2] row_mask:0xf bank_mask:0xf
    s_waitcnt vmcnt(7)
    global_load_dwordx4 v[112:115], v36, s[20:21] offset:-4096 nt
    v_mfma_f32_16x16x32_bf16 v[152:155], v[144:147], v[80:83], v[152:155]
    s_waitcnt vmcnt(7)
    global_load_dwordx4 v[116:119], v36, s[20:21] offset:0 nt
    v_mfma_f32_16x16x32_bf16 v[156:159], v[144:147], v[84:87], v[156:159]
    v_and_b32_dpp v148, v11, v26 quad_perm:[2,2,2,2] row_mask:0xf bank_mask:0xf
    v_and_b32_dpp v149, v11, v27 quad_perm:[2,2,2,2] row_mask:0xf bank_mask:0xf
    v_and_b32_dpp v150, v11, v28 quad_perm:[2,2,2,2] row_mask:0xf bank_mask:0xf
    v_and_b32_dpp v151, v11, v29 quad_perm:[2,2,2,2] row_mask:0xf bank_mask:0xf
    s_waitcnt vmcnt(7)
    v_add_u32 v36, 0x2000, v36
    global_load_dwordx4 v[120:123], v36, s[20:21] offset:-4096 nt
    v_mfma_f32_16x16x32_bf16 v[152:155], v[148:151], v[88:91], v[152:155]
    s_waitcnt vmcnt(7)
    global_load_dwordx4 v[124:127], v36, s[20:21] offset:0 nt
    v_mfma_f32_16x16x32_bf16 v[156:159], v[148:151], v[92:95], v[156:159]
    v_and_b32_dpp v144, v10, v26 quad_perm:[3,3,3,3] row_mask:0xf bank_mask:0xf
    v_and_b32_dpp v145, v10, v27 quad_perm:[3,3,3,3] row_mask:0xf bank_mask:0xf
    v_and_b32_dpp v146, v10, v28 quad_perm:[3,3,3,3] row_mask:0xf bank_mask:0xf
    v_and_b32_dpp v147, v10, v29 quad_perm:[3,3,3,3] row_mask:0xf bank_mask:0xf
    s_waitcnt vmcnt(7)
    v_add_u32 v36, 0x2000, v36
    global_load_dwordx4 v[128:131], v36, s[20:21] offset:-4096 nt
    v_mfma_f32_16x16x32_bf16 v[152:155], v[144:147], v[96:99], v[152:155]
    s_waitcnt vmcnt(7)
    global_load_dwordx4 v[132:135], v36, s[20:21] offset:0 nt
    v_mfma_f32_16x16x32_bf16 v[156:159], v[144:147], v[100:103], v[156:159]
    v_and_b32_dpp v148, v11, v26 quad_perm:[3,3,3,3] row_mask:0xf bank_mask:0xf
    v_and_b32_dpp v149, v11, v27 quad_perm:[3,3,3,3] row_mask:0xf bank_mask:0xf
    v_and_b32_dpp v150, v11, v28 quad_perm:[3,3,3,3] row_mask:0xf bank_mask:0xf
    v_and_b32_dpp v151, v11, v29 quad_perm:[3,3,3,3] row_mask:0xf bank_mask:0xf
    s_waitcnt vmcnt(7)
    v_add_u32 v36, 0x2000, v36
    global_load_dwordx4 v[136:139], v36, s[20:21] offset:-4096 nt
    v_mfma_f32_16x16x32_bf16 v[152:155], v[148:151], v[104:107], v[152:155]
    s_waitcnt vmcnt(7)
    global_load_dwordx4 v[140:143], v36, s[20:21] offset:0 nt
    v_mfma_f32_16x16x32_bf16 v[156:159], v[148:151], v[108:111], v[156:159]
    s_nop 7
    v_permlane32_swap_b32 v152, v156
    v_permlane32_swap_b32 v153, v157
    v_permlane32_swap_b32 v154, v158
    v_permlane32_swap_b32 v155, v159
    v_add_f32_dpp v152, v156, v152 row_ror:8 row_mask:0xf bank_mask:0xf
    v_add_f32_dpp v153, v157, v153 row_ror:8 row_mask:0xf bank_mask:0xf
    v_add_f32_dpp v154, v158, v154 row_ror:8 row_mask:0xf bank_mask:0xf
    v_add_f32_dpp v155, v159, v155 row_ror:8 row_mask:0xf bank_mask:0xf
    v_and_or_b32 v152, v152, v33, s43
    v_and_or_b32 v153, v153, v33, s37
    v_and_or_b32 v154, v154, v33, s38
    v_and_or_b32 v155, v155, v33, s39
    s_mov_b32 exec_lo, 0x00ff00ff
    s_mov_b32 exec_hi, 0x00ff00ff
    global_store_dwordx4 v37, v[152:155], s[26:27]
    s_mov_b64 exec, -1
    global_load_short_d16_hi v42, v30, s[4:5]
    s_barrier
    s_barrier
    s_waitcnt vmcnt(0)
    global_load_dwordx4 v[48:51], v38, s[26:27] sc1
    global_load_dwordx4 v[52:55], v38, s[26:27] offset:256 sc1
    s_barrier
    s_load_dwordx8 s[4:11], s[24:25], 0 glc
    s_waitcnt vmcnt(0)
    s_mov_b32 s41, 0
L_f_chk:
    v_xor_b32 v48, s43, v48
    v_xor_b32 v49, s37, v49
    v_xor_b32 v50, s38, v50
    v_xor_b32 v51, s39, v51
    v_xor_b32 v52, s43, v52
    v_xor_b32 v53, s37, v53
    v_xor_b32 v54, s38, v54
    v_xor_b32 v55, s39, v55
    v_or3_b32 v2, v48, v49, v50
    v_or3_b32 v2, v2, v51, v52
    v_or3_b32 v2, v2, v53, v54
    v_or_b32 v2, v2, v55
    v_cmp_ne_u32_sdwa vcc, v2, 0 src0_sel:BYTE_0 src1_sel:DWORD
    s_nop 0
    s_and_b64 exec, exec, vcc
    s_cbranch_scc1 L_f_re
L_f_ok:
    s_mov_b64 exec, -1
    v_permlane32_swap_b32 v48, v50
    v_permlane32_swap_b32 v49, v51
    v_permlane32_swap_b32 v52, v54
    v_permlane32_swap_b32 v53, v55
    v_pk_add_f32 v[48:49], v[48:49], v[50:51]
    v_pk_add_f32 v[52:53], v[52:53], v[54:55]
    s_nop 0
    v_permlane16_swap_b32 v48, v49
    v_permlane16_swap_b32 v52, v53
    v_add_f32 v48, v48, v49
    v_add_f32 v52, v52, v53
    s_nop 0
    v_add_f32_dpp v48, v48, v48 row_ror:8 row_mask:0xf bank_mask:0xf
    v_add_f32_dpp v52, v52, v52 row_ror:8 row_mask:0xf bank_mask:0xf
    v_cvt_pk_bf16_f32 v2, v48, v52
    v_lshlrev_b32 v48, 16, v2
    v_and_b32 v49, 0xffff0000, v2
    v_mul_f32 v2, 0xbfb8aa3b, v48
    v_exp_f32 v2, v2
    s_nop 0
    v_add_f32 v2, 1.0, v2
    v_rcp_f32 v2, v2
    s_nop 0
    v_mul_f32 v48, v48, v2
    v_cvt_pk_bf16_f32 v48, v48, v48
    v_lshlrev_b32 v48, 16, v48
    v_mul_f32 v48, v48, v49
    v_cvt_pk_bf16_f32 v48, v48, v48
    s_nop 1
    v_and_b32_dpp v144, v48, v26 row_newbcast:0 row_mask:0xf bank_mask:0xf
    v_and_b32_dpp v145, v48, v27 row_newbcast:0 row_mask:0xf bank_mask:0xf
    v_and_b32_dpp v146, v48, v28 row_newbcast:0 row_mask:0xf bank_mask:0xf
    v_and_b32_dpp v147, v48, v29 row_newbcast:0 row_mask:0xf bank_mask:0xf
    s_nop 1
    v_mfma_f32_16x16x32_bf16 v[156:159], v[144:147], v[112:115], 0
    v_and_b32_dpp v148, v48, v26 row_newbcast:1 row_mask:0xf bank_mask:0xf
    v_and_b32_dpp v149, v48, v27 row_newbcast:1 row_mask:0xf bank_mask:0xf
    v_and_b32_dpp v150, v48, v28 row_newbcast:1 row_mask:0xf bank_mask:0xf
    v_and_b32_dpp v151, v48, v29 row_newbcast:1 row_mask:0xf bank_mask:0xf
    s_nop 1
    v_mfma_f32_16x16x32_bf16 v[156:159], v[148:151], v[116:119], v[156:159]
    v_and_b32_dpp v144, v48, v26 row_newbcast:2 row_mask:0xf bank_mask:0xf
    v_and_b32_dpp v145, v48, v27 row_newbcast:2 row_mask:0xf bank_mask:0xf
    v_and_b32_dpp v146, v48, v28 row_newbcast:2 row_mask:0xf bank_mask:0xf
    v_and_b32_dpp v147, v48, v29 row_newbcast:2 row_mask:0xf bank_mask:0xf
    s_nop 1
    v_mfma_f32_16x16x32_bf16 v[156:159], v[144:147], v[120:123], v[156:159]
    v_and_b32_dpp v148, v48, v26 row_newbcast:3 row_mask:0xf bank_mask:0xf
    v_and_b32_dpp v149, v48, v27 row_newbcast:3 row_mask:0xf bank_mask:0xf
    v_and_b32_dpp v150, v48, v28 row_newbcast:3 row_mask:0xf bank_mask:0xf
    v_and_b32_dpp v151, v48, v29 row_newbcast:3 row_mask:0xf bank_mask:0xf
    s_nop 1
    v_mfma_f32_16x16x32_bf16 v[156:159], v[148:151], v[124:127], v[156:159]
    v_and_b32_dpp v144, v48, v26 row_newbcast:4 row_mask:0xf bank_mask:0xf
    v_and_b32_dpp v145, v48, v27 row_newbcast:4 row_mask:0xf bank_mask:0xf
    v_and_b32_dpp v146, v48, v28 row_newbcast:4 row_mask:0xf bank_mask:0xf
    v_and_b32_dpp v147, v48, v29 row_newbcast:4 row_mask:0xf bank_mask:0xf
    s_nop 1
    v_mfma_f32_16x16x32_bf16 v[156:159], v[144:147], v[128:131], v[156:159]
    v_and_b32_dpp v148, v48, v26 row_newbcast:5 row_mask:0xf bank_mask:0xf
    v_and_b32_dpp v149, v48, v27 row_newbcast:5 row_mask:0xf bank_mask:0xf
    v_and_b32_dpp v150, v48, v28 row_newbcast:5 row_mask:0xf bank_mask:0xf
    v_and_b32_dpp v151, v48, v29 row_newbcast:5 row_mask:0xf bank_mask:0xf
    s_nop 1
    v_mfma_f32_16x16x32_bf16 v[156:159], v[148:151], v[132:135], v[156:159]
    v_and_b32_dpp v144, v48, v26 row_newbcast:6 row_mask:0xf bank_mask:0xf
    v_and_b32_dpp v145, v48, v27 row_newbcast:6 row_mask:0xf bank_mask:0xf
    v_and_b32_dpp v146, v48, v28 row_newbcast:6 row_mask:0xf bank_mask:0xf
    v_and_b32_dpp v147, v48, v29 row_newbcast:6 row_mask:0xf bank_mask:0xf
    s_nop 1
    v_mfma_f32_16x16x32_bf16 v[156:159], v[144:147], v[136:139], v[156:159]
    v_and_b32_dpp v148, v48, v26 row_newbcast:7 row_mask:0xf bank_mask:0xf
    v_and_b32_dpp v149, v48, v27 row_newbcast:7 row_mask:0xf bank_mask:0xf
    v_and_b32_dpp v150, v48, v28 row_newbcast:7 row_mask:0xf bank_mask:0xf
    v_and_b32_dpp v151, v48, v29 row_newbcast:7 row_mask:0xf bank_mask:0xf
    s_nop 1
    v_mfma_f32_16x16x32_bf16 v[156:159], v[148:151], v[140:143], v[156:159]
L_ytag:
    s_mov_b32 exec_hi, 0
    s_nop 6
    ds_write_b128 v34, v[156:159] offset:12288
    s_mov_b64 exec, -1
    s_mov_b32 s32, s33
    s_mov_b32 s41, 100000
    s_waitcnt lgkmcnt(0)
    s_barrier
L_h:
    s_load_dwordx8 s[4:11], s[24:25], 0 glc
    s_sub_u32 s41, s41, 1
    s_cbranch_scc1 L_hok
    s_waitcnt lgkmcnt(0)
    s_xor_b64 s[12:13], s[4:5], s[32:33]
    s_xor_b64 s[14:15], s[6:7], s[32:33]
    s_xor_b64 s[16:17], s[8:9], s[32:33]
    s_xor_b64 s[18:19], s[10:11], s[32:33]
    s_or_b64 s[12:13], s[12:13], s[14:15]
    s_or_b64 s[16:17], s[16:17], s[18:19]
    s_or_b64 s[12:13], s[12:13], s[16:17]
    s_cbranch_scc1 L_h
L_hok:
    s_mov_b32 s41, 100000
L_s:
    global_load_dwordx4 v[18:21], v40, s[26:27] sc1
L_s_w:
    s_sub_u32 s41, s41, 1
    s_cselect_b64 s[34:35], 0, exec
    s_waitcnt vmcnt(0)
    v_xor_b32 v18, s36, v18
    v_xor_b32 v19, s37, v19
    v_xor_b32 v20, s38, v20
    v_xor_b32 v21, s39, v21
    v_or3_b32 v2, v18, v19, v20
    v_or_b32 v2, v2, v21
    v_cmp_ne_u32_sdwa vcc, v2, 0 src0_sel:BYTE_0 src1_sel:DWORD
    s_nop 0
    s_and_b64 exec, s[34:35], vcc
    s_cbranch_scc1 L_s
    s_mov_b64 exec, -1
    v_permlane32_swap_b32 v18, v20
    v_permlane32_swap_b32 v19, v21
    v_pk_add_f32 v[18:19], v[18:19], v[20:21]
    s_nop 1
    v_permlane16_swap_b32 v18, v19
    v_add_f32 v18, v18, v19
    s_nop 1
    v_add_f32_dpp v18, v18, v18 row_ror:8 row_mask:0xf bank_mask:0xf
    s_nop 1
    v_add_f32_dpp v18, v18, v18 row_ror:4 row_mask:0xf bank_mask:0xf
    s_nop 1
    v_add_f32_dpp v18, v18, v18 row_ror:2 row_mask:0xf bank_mask:0xf
    s_nop 1
    v_add_f32_dpp v18, v18, v18 row_ror:1 row_mask:0xf bank_mask:0xf
    v_cvt_pk_bf16_f32 v18, v18, v18
    v_lshlrev_b32 v18, 16, v18
    v_mul_f32 v2, 0xbfb8aa3b, v18
    v_exp_f32 v2, v2
    v_mov_b32 v10, v18
    v_add_f32 v2, 1.0, v2
    v_rcp_f32 v2, v2
    v_permlane32_swap_b32 v12, v10
    v_mul_f32 v18, v18, v2
    v_cvt_pk_bf16_f32 v18, v18, v18
    v_lshlrev_b32 v18, 16, v18
    s_mov_b32 exec_lo, 0
    s_mov_b32 exec_hi, 0x00010001
    v_mul_f32 v10, v12, v18
    v_cvt_pk_bf16_f32 v10, v10, v10
    v_lshlrev_b32 v10, 16, v10
    v_add_f32 v10, v10, v42
    v_cvt_pk_bf16_f32 v10, v10, v10
    global_store_short v30, v10, s[22:23]
    s_cmp_lg_u32 s45, 0
    s_cbranch_scc1 L_done
    s_mov_b64 exec, 1
    v_mov_b32 v2, 0
    v_mov_b32 v3, s33
    global_store_dword v2, v3, s[26:27]
L_done:
    s_endpgm
L_q_re:
    s_add_u32 s41, s41, 1
    s_cmp_ge_u32 s41, 100000
    s_cbranch_scc1 L_q_ok
    s_cmp_lt_u32 s41, 4
    s_cbranch_scc1 L_q_same
    s_cmp_lg_u32 s41, 4
    s_cbranch_scc1 L_q_tog
    s_mov_b64 s[30:31], exec
    s_mov_b32 exec_lo, 0xff00ff
    s_mov_b32 exec_hi, 0x0
    s_mov_b32 s44, 1
    v_and_or_b32 v118, v118, v33, s36
    v_xor_b32 v36, 0x30000, v36
    global_store_dwordx4 v36, v[118:121], s[26:27] sc1
    s_mov_b64 exec, s[30:31]
L_q_tog:
    s_xor_b32 s43, s43, s42
    v_xor_b32 v37, 0x30000, v37
L_q_same:
    global_load_dwordx4 v[122:125], v37, s[26:27] offset:-4096 sc1
    global_load_dwordx4 v[126:129], v37, s[26:27] offset:-3072 sc1
    global_load_dwordx4 v[130:133], v37, s[26:27] offset:-2048 sc1
    global_load_dwordx4 v[134:137], v37, s[26:27] offset:-1024 sc1
    global_load_dwordx4 v[138:141], v37, s[26:27] offset:0 sc1
    global_load_dwordx4 v[142:145], v37, s[26:27] offset:1024 sc1
    global_load_dwordx4 v[146:149], v37, s[26:27] offset:2048 sc1
    global_load_dwordx4 v[150:153], v37, s[26:27] offset:3072 sc1
    s_waitcnt vmcnt(0)
    s_branch L_q_chk
L_oslow:
    global_store_dwordx4 v43, v[150:153], s[26:27] sc1
    s_branch L_opub
L_f_re:
    s_add_u32 s41, s41, 1
    s_cmp_ge_u32 s41, 100000
    s_cbranch_scc1 L_f_ok
    s_cmp_lt_u32 s41, 4
    s_cbranch_scc1 L_f_same
    s_cmp_lg_u32 s41, 4
    s_cbranch_scc1 L_f_tog
    s_mov_b64 s[30:31], exec
    s_mov_b32 exec_lo, 0xff00ff
    s_mov_b32 exec_hi, 0xff00ff
    s_mov_b32 s44, 1
    v_and_or_b32 v152, v152, v33, s36
    v_xor_b32 v37, 0x20000, v37
    global_store_dwordx4 v37, v[152:155], s[26:27] sc1
    s_mov_b64 exec, s[30:31]
L_f_tog:
    s_xor_b32 s43, s43, s42
    v_xor_b32 v38, 0x20000, v38
L_f_same:
    global_load_dwordx4 v[48:51], v38, s[26:27] sc1
    global_load_dwordx4 v[52:55], v38, s[26:27] offset:256 sc1
    s_waitcnt vmcnt(0)
    s_branch L_f_chk
L_end:
    s_endpgm
.section .rodata,"a"
.p2align 6
.amdhsa_kernel recurrent_scan__sliding_block_cached__swiglu_ffn__decode_kernel
  .amdhsa_next_free_vgpr 160
  .amdhsa_next_free_sgpr 52
  .amdhsa_accum_offset 160
  .amdhsa_group_segment_fixed_size 0
  .amdhsa_kernarg_size 96
  .amdhsa_user_sgpr_count 2
  .amdhsa_user_sgpr_kernarg_segment_ptr 1
  .amdhsa_system_sgpr_workgroup_id_x 1
  .amdhsa_float_denorm_mode_32 3
.end_amdhsa_kernel
```
